```python
import torch

def _softmax(x, axis=-1):
    return torch.softmax(x, dim=axis)
def _gelu(x):
    return torch.nn.functional.gelu(x, approximate="tanh")
def _silu(x):
    return torch.nn.functional.silu(x)
def _sigmoid(x):
    return torch.sigmoid(x)
def _layernorm(x, axis=-1, eps=1e-5):
    m = x.mean(dim=axis, keepdim=True)
    v = x.var(dim=axis, keepdim=True, unbiased=False)
    return (x - m) / torch.sqrt(v + eps)
def _scatter_add(tgt, idx, src, axis=0):
    return tgt.clone().index_add_(axis, idx, src)
def _segment_sum(src, seg, n):
    out = torch.zeros((n,) + src.shape[1:], dtype=src.dtype)
    return out.index_add_(0, seg, src)
def _pad(x, pw):
    flat = tuple(v for pair in reversed(pw) for v in pair)
    return torch.nn.functional.pad(x, flat)

kernel_name = 'standalone__low_rank_proj_linformer__decode'

def setup_inputs():

    _w = (lambda a: (lambda t: t.to(torch.bfloat16) if t.is_floating_point() else t)(torch.as_tensor(a)))
    B, H, Sq, Skv, Dh, R = 8, 32, 1, 4096, 128, 8
    return {
        "q": _w((lambda *s: torch.randn(*s, dtype=torch.bfloat16) * 0.8)(B, H, Sq, Dh)),
        "k": _w((lambda *s: torch.randn(*s, dtype=torch.bfloat16) * 0.8)(B, H, Skv, Dh)),
        "v": _w((lambda *s: torch.randn(*s, dtype=torch.bfloat16) * 0.05)(B, H, Skv, Dh)),
        "e_proj": _w((lambda *s: torch.randn(*s, dtype=torch.bfloat16) * 0.8)(R, Skv) * (Skv ** -0.5)),
        "f_proj": _w((lambda *s: torch.randn(*s, dtype=torch.bfloat16) * 0.05)(R, Skv) * (Skv ** -0.5)),
    }

def reference(q, k, v, e_proj, f_proj):
    B, H, Sq, Dh = q.shape
    kp = torch.einsum("rn,bhnd->bhrd", e_proj, k)
    vp = torch.einsum("rn,bhnd->bhrd", f_proj, v)
    scores = torch.einsum("bhqd,bhrd->bhqr", q, kp) * (Dh ** -0.5)
    p = _softmax(scores, axis=-1)
    o = torch.einsum("bhqr,bhrd->bhqd", p, vp)
    return o
```

```asm
; @launch grid=(256,1,1) block=(256,1,1) lds=86016
.amdgcn_target "amdgcn-amd-amdhsa--gfx950"
.text
.globl standalone__low_rank_proj_linformer__decode_kernel
.p2align 8
.type standalone__low_rank_proj_linformer__decode_kernel,@function
standalone__low_rank_proj_linformer__decode_kernel:
  s_lshr_b32 s20, s2, 8
  s_cbranch_scc1 L_end
  s_load_dwordx16 s[4:19], s[0:1], 0
  s_lshr_b32 s21, s2, 3
  s_add_u32 s21, s21, s2
  s_and_b32 s21, s21, 7
  s_andn2_b32 s2, s2, 7
  s_or_b32 s2, s2, s21
  v_lshrrev_b32 v1, 6, v0
  v_and_b32 v3, 15, v0
  v_readfirstlane_b32 s40, v1
  v_bfe_u32 v9, v0, 4, 2
  v_lshlrev_b32 v3, 4, v3
  v_lshl_add_u32 v1, v9, 13, v3
  s_lshl_b32 s22, 1, 20
  s_lshl_b32 s23, 1, 17
  s_lshl_b32 s47, s2, 20
  s_lshl_b32 s42, s40, 11
  s_waitcnt lgkmcnt(0)
  s_add_u32 s20, s6, s47
  s_addc_u32 s21, s7, 0
  buffer_load_dwordx4 v[56:59], v1, s[20:23], s42 offen offset:0 nt
  buffer_load_dwordx4 v[60:63], v1, s[20:23], s42 offen offset:256 nt
  buffer_load_dwordx4 v[64:67], v1, s[20:23], s42 offen offset:512 nt
  buffer_load_dwordx4 v[68:71], v1, s[20:23], s42 offen offset:768 nt
  buffer_load_dwordx4 v[72:75], v1, s[20:23], s42 offen offset:1024 nt
  buffer_load_dwordx4 v[76:79], v1, s[20:23], s42 offen offset:1280 nt
  buffer_load_dwordx4 v[80:83], v1, s[20:23], s42 offen offset:1536 nt
  buffer_load_dwordx4 v[84:87], v1, s[20:23], s42 offen offset:1792 nt
  v_and_b32 v0, 63, v0
  v_and_b32 v8, 15, v0
  v_lshlrev_b32 v10, 13, v8
  v_lshl_add_u32 v2, v9, 6, v10
  s_mov_b32 s24, s10
  s_mov_b32 s25, s11
  s_mov_b32 s26, 0x10000
  s_mov_b32 s27, 0x20000
  s_mov_b32 s44, s42
  s_lshr_b32 s43, s42, 7
  buffer_load_dwordx4 v[88:91], v2, s[24:27], s43 offen
  s_add_u32 s42, s42, 32768
  s_add_u32 s50, s8, s47
  s_addc_u32 s51, s9, 0
  s_mov_b32 s28, s4
  s_mov_b32 s29, s5
  s_mov_b32 s30, 0x10000
  s_mov_b32 s31, 0x20000
  s_lshl_b32 s47, s2, 8
  buffer_load_dwordx4 v[20:23], v3, s[28:31], s47 offen
  s_cmp_lg_u32 s40, 1
  s_cbranch_scc1 L_nocpf
  s_getpc_b64 s[86:87]
L_pc:
  s_sub_u32 s86, s86, L_pc-standalone__low_rank_proj_linformer__decode_kernel
  s_subb_u32 s87, s87, 0
  v_lshlrev_b32 v12, 6, v0
  s_mov_b32 s47, L_codeend-standalone__low_rank_proj_linformer__decode_kernel-4
  v_min_u32 v13, s47, v12
  global_load_dword v128, v13, s[86:87]
  v_add_u32 v12, 4096, v12
  v_min_u32 v13, s47, v12
  global_load_dword v129, v13, s[86:87]
  v_add_u32 v12, 4096, v12
L_nocpf:
  s_mov_b32 s45, 0x05040100
  s_mov_b32 s46, 0x07060302
  v_mov_b32 v24, 0
  v_mov_b32 v25, 0
  v_mov_b32 v26, 0
  v_mov_b32 v27, 0
  v_mov_b32 v28, 0
  v_mov_b32 v29, 0
  v_mov_b32 v30, 0
  v_mov_b32 v31, 0
  v_mov_b32 v32, 0
  v_mov_b32 v33, 0
  v_mov_b32 v34, 0
  v_mov_b32 v35, 0
  v_mov_b32 v36, 0
  v_mov_b32 v37, 0
  v_mov_b32 v38, 0
  v_mov_b32 v39, 0
  v_mov_b32 v40, 0
  v_mov_b32 v41, 0
  v_mov_b32 v42, 0
  v_mov_b32 v43, 0
  v_mov_b32 v44, 0
  v_mov_b32 v45, 0
  v_mov_b32 v46, 0
  v_mov_b32 v47, 0
  v_mov_b32 v48, 0
  v_mov_b32 v49, 0
  v_mov_b32 v50, 0
  v_mov_b32 v51, 0
  v_mov_b32 v52, 0
  v_mov_b32 v53, 0
  v_mov_b32 v54, 0
  v_mov_b32 v55, 0
  v_lshlrev_b32 v4, 4, v0
  s_lshl_b32 s47, s40, 12
  s_add_u32 s47, s47, 512
  v_add_u32 v4, s47, v4
  v_lshlrev_b32 v156, 4, v0
  s_lshl_b32 s47, s40, 10
  s_add_u32 s47, s47, 512
  v_add_u32 v132, s47, v156
  s_mov_b32 s28, s14
  s_mov_b32 s29, s15
  s_lshl_b32 s48, s2, 8
  s_lshl_b32 s49, s40, 2
  s_add_u32 s49, s49, s48
  s_lshr_b32 s43, s42, 7
  buffer_load_dwordx4 v[124:127], v2, s[24:27], s43 offen
  buffer_load_dwordx4 v[92:95], v1, s[20:23], s42 offen offset:0 nt
  buffer_load_dwordx4 v[96:99], v1, s[20:23], s42 offen offset:256 nt
  buffer_load_dwordx4 v[100:103], v1, s[20:23], s42 offen offset:512 nt
  buffer_load_dwordx4 v[104:107], v1, s[20:23], s42 offen offset:768 nt
  buffer_load_dwordx4 v[108:111], v1, s[20:23], s42 offen offset:1024 nt
  buffer_load_dwordx4 v[112:115], v1, s[20:23], s42 offen offset:1280 nt
  buffer_load_dwordx4 v[116:119], v1, s[20:23], s42 offen offset:1536 nt
  buffer_load_dwordx4 v[120:123], v1, s[20:23], s42 offen offset:1792 nt
  s_add_u32 s42, s42, 32768
  s_mov_b32 s41, 0
L_loop:
  s_cmp_eq_u32 s41, 15
  s_cbranch_scc0 L_noswitch
  s_mov_b32 s20, s50
  s_mov_b32 s21, s51
  s_mov_b32 s24, s12
  s_mov_b32 s25, s13
  s_mov_b32 s42, s44
L_noswitch:
  s_cmp_eq_u32 s41, 16
  s_cbranch_scc1 L_trans
L_body:
  s_waitcnt vmcnt(9)
  v_perm_b32 v12, v60, v56, s45
  v_perm_b32 v13, v68, v64, s45
  v_perm_b32 v14, v76, v72, s45
  v_perm_b32 v15, v84, v80, s45
  v_perm_b32 v16, v60, v56, s46
  v_perm_b32 v17, v68, v64, s46
  v_perm_b32 v18, v76, v72, s46
  v_perm_b32 v19, v84, v80, s46
  v_mfma_f32_16x16x32_bf16 v[24:27], v[88:91], v[12:15], v[24:27]
  v_perm_b32 v12, v61, v57, s45
  v_perm_b32 v13, v69, v65, s45
  v_perm_b32 v14, v77, v73, s45
  v_perm_b32 v15, v85, v81, s45
  v_mfma_f32_16x16x32_bf16 v[28:31], v[88:91], v[16:19], v[28:31]
  v_perm_b32 v16, v61, v57, s46
  v_perm_b32 v17, v69, v65, s46
  v_perm_b32 v18, v77, v73, s46
  v_perm_b32 v19, v85, v81, s46
  v_mfma_f32_16x16x32_bf16 v[32:35], v[88:91], v[12:15], v[32:35]
  v_perm_b32 v12, v62, v58, s45
  v_perm_b32 v13, v70, v66, s45
  v_perm_b32 v14, v78, v74, s45
  v_perm_b32 v15, v86, v82, s45
  v_mfma_f32_16x16x32_bf16 v[36:39], v[88:91], v[16:19], v[36:39]
  v_perm_b32 v16, v62, v58, s46
  v_perm_b32 v17, v70, v66, s46
  v_perm_b32 v18, v78, v74, s46
  v_perm_b32 v19, v86, v82, s46
  v_mfma_f32_16x16x32_bf16 v[40:43], v[88:91], v[12:15], v[40:43]
  v_perm_b32 v12, v63, v59, s45
  v_perm_b32 v13, v71, v67, s45
  v_perm_b32 v14, v79, v75, s45
  v_perm_b32 v15, v87, v83, s45
  v_mfma_f32_16x16x32_bf16 v[44:47], v[88:91], v[16:19], v[44:47]
  v_perm_b32 v16, v63, v59, s46
  v_perm_b32 v17, v71, v67, s46
  v_perm_b32 v18, v79, v75, s46
  v_perm_b32 v19, v87, v83, s46
  v_mfma_f32_16x16x32_bf16 v[48:51], v[88:91], v[12:15], v[48:51]
  s_nop 1
  v_mfma_f32_16x16x32_bf16 v[52:55], v[88:91], v[16:19], v[52:55]
  s_lshr_b32 s43, s42, 7
  buffer_load_dwordx4 v[88:91], v2, s[24:27], s43 offen
  s_waitcnt vmcnt(5)
  buffer_load_dwordx4 v[56:59], v1, s[20:23], s42 offen offset:0 nt
  s_waitcnt vmcnt(5)
  buffer_load_dwordx4 v[60:63], v1, s[20:23], s42 offen offset:256 nt
  s_waitcnt vmcnt(5)
  buffer_load_dwordx4 v[64:67], v1, s[20:23], s42 offen offset:512 nt
  s_waitcnt vmcnt(5)
  buffer_load_dwordx4 v[68:71], v1, s[20:23], s42 offen offset:768 nt
  s_waitcnt vmcnt(5)
  buffer_load_dwordx4 v[72:75], v1, s[20:23], s42 offen offset:1024 nt
  s_waitcnt vmcnt(5)
  buffer_load_dwordx4 v[76:79], v1, s[20:23], s42 offen offset:1280 nt
  s_waitcnt vmcnt(5)
  buffer_load_dwordx4 v[80:83], v1, s[20:23], s42 offen offset:1536 nt
  s_waitcnt vmcnt(5)
  buffer_load_dwordx4 v[84:87], v1, s[20:23], s42 offen offset:1792 nt
  s_add_u32 s42, s42, 32768
  s_waitcnt vmcnt(9)
  v_perm_b32 v12, v96, v92, s45
  v_perm_b32 v13, v104, v100, s45
  v_perm_b32 v14, v112, v108, s45
  v_perm_b32 v15, v120, v116, s45
  v_perm_b32 v16, v96, v92, s46
  v_perm_b32 v17, v104, v100, s46
  v_perm_b32 v18, v112, v108, s46
  v_perm_b32 v19, v120, v116, s46
  v_mfma_f32_16x16x32_bf16 v[24:27], v[124:127], v[12:15], v[24:27]
  v_perm_b32 v12, v97, v93, s45
  v_perm_b32 v13, v105, v101, s45
  v_perm_b32 v14, v113, v109, s45
  v_perm_b32 v15, v121, v117, s45
  v_mfma_f32_16x16x32_bf16 v[28:31], v[124:127], v[16:19], v[28:31]
  v_perm_b32 v16, v97, v93, s46
  v_perm_b32 v17, v105, v101, s46
  v_perm_b32 v18, v113, v109, s46
  v_perm_b32 v19, v121, v117, s46
  v_mfma_f32_16x16x32_bf16 v[32:35], v[124:127], v[12:15], v[32:35]
  v_perm_b32 v12, v98, v94, s45
  v_perm_b32 v13, v106, v102, s45
  v_perm_b32 v14, v114, v110, s45
  v_perm_b32 v15, v122, v118, s45
  v_mfma_f32_16x16x32_bf16 v[36:39], v[124:127], v[16:19], v[36:39]
  v_perm_b32 v16, v98, v94, s46
  v_perm_b32 v17, v106, v102, s46
  v_perm_b32 v18, v114, v110, s46
  v_perm_b32 v19, v122, v118, s46
  v_mfma_f32_16x16x32_bf16 v[40:43], v[124:127], v[12:15], v[40:43]
  v_perm_b32 v12, v99, v95, s45
  v_perm_b32 v13, v107, v103, s45
  v_perm_b32 v14, v115, v111, s45
  v_perm_b32 v15, v123, v119, s45
  v_mfma_f32_16x16x32_bf16 v[44:47], v[124:127], v[16:19], v[44:47]
  v_perm_b32 v16, v99, v95, s46
  v_perm_b32 v17, v107, v103, s46
  v_perm_b32 v18, v115, v111, s46
  v_perm_b32 v19, v123, v119, s46
  v_mfma_f32_16x16x32_bf16 v[48:51], v[124:127], v[12:15], v[48:51]
  s_nop 1
  v_mfma_f32_16x16x32_bf16 v[52:55], v[124:127], v[16:19], v[52:55]
  s_lshr_b32 s43, s42, 7
  buffer_load_dwordx4 v[124:127], v2, s[24:27], s43 offen
  s_waitcnt vmcnt(5)
  buffer_load_dwordx4 v[92:95], v1, s[20:23], s42 offen offset:0 nt
  s_waitcnt vmcnt(5)
  buffer_load_dwordx4 v[96:99], v1, s[20:23], s42 offen offset:256 nt
  s_waitcnt vmcnt(5)
  buffer_load_dwordx4 v[100:103], v1, s[20:23], s42 offen offset:512 nt
  s_waitcnt vmcnt(5)
  buffer_load_dwordx4 v[104:107], v1, s[20:23], s42 offen offset:768 nt
  s_waitcnt vmcnt(5)
  buffer_load_dwordx4 v[108:111], v1, s[20:23], s42 offen offset:1024 nt
  s_waitcnt vmcnt(5)
  buffer_load_dwordx4 v[112:115], v1, s[20:23], s42 offen offset:1280 nt
  s_waitcnt vmcnt(5)
  buffer_load_dwordx4 v[116:119], v1, s[20:23], s42 offen offset:1536 nt
  s_waitcnt vmcnt(5)
  buffer_load_dwordx4 v[120:123], v1, s[20:23], s42 offen offset:1792 nt
  s_add_u32 s42, s42, 32768
  s_add_u32 s41, s41, 1
  s_cmp_lt_u32 s41, 27
  s_cbranch_scc1 L_loop
  v_and_b32 v136, 16, v0
  s_waitcnt lgkmcnt(0)
  s_barrier
  ds_read_b128 v[140:143], v136 offset:0
  ds_read_b128 v[144:147], v136 offset:32
  ds_read_b128 v[148:151], v136 offset:64
  ds_read_b128 v[152:155], v136 offset:96
  s_waitcnt lgkmcnt(0)
  v_add_f32 v140, v140, v144
  v_add_f32 v148, v148, v152
  v_add_f32 v141, v141, v145
  v_add_f32 v149, v149, v153
  v_add_f32 v142, v142, v146
  v_add_f32 v150, v150, v154
  v_add_f32 v143, v143, v147
  v_add_f32 v151, v151, v155
  v_add_f32 v128, v140, v148
  v_add_f32 v129, v141, v149
  v_add_f32 v130, v142, v150
  v_add_f32 v131, v143, v151
  v_cvt_pk_bf16_f32 v136, v128, v129
  v_cvt_pk_bf16_f32 v137, v130, v131
  v_lshlrev_b32 v128, 16, v136
  v_and_b32 v129, 0xffff0000, v136
  v_lshlrev_b32 v130, 16, v137
  v_and_b32 v131, 0xffff0000, v137
  v_mul_f32 v128, 0x3db504f3, v128
  v_mul_f32 v129, 0x3db504f3, v129
  v_mul_f32 v130, 0x3db504f3, v130
  v_mul_f32 v131, 0x3db504f3, v131
  v_cvt_pk_bf16_f32 v136, v128, v129
  v_cvt_pk_bf16_f32 v137, v130, v131
  v_lshlrev_b32 v128, 16, v136
  v_and_b32 v129, 0xffff0000, v136
  v_lshlrev_b32 v130, 16, v137
  v_and_b32 v131, 0xffff0000, v137
  v_max3_f32 v138, v128, v129, v130
  v_max_f32 v138, v138, v131
  v_mov_b32 v139, v138
  s_nop 1
  v_permlane16_swap_b32 v138, v139
  s_nop 0
  v_max_f32 v138, v138, v139
  v_sub_f32 v128, v128, v138
  v_sub_f32 v129, v129, v138
  v_sub_f32 v130, v130, v138
  v_sub_f32 v131, v131, v138
  v_mul_f32 v128, 0x3fb8aa3b, v128
  v_mul_f32 v129, 0x3fb8aa3b, v129
  v_mul_f32 v130, 0x3fb8aa3b, v130
  v_mul_f32 v131, 0x3fb8aa3b, v131
  v_exp_f32 v128, v128
  v_exp_f32 v129, v129
  v_exp_f32 v130, v130
  v_exp_f32 v131, v131
  s_nop 0
  v_add_f32 v138, v128, v129
  v_add_f32 v139, v130, v131
  v_add_f32 v138, v138, v139
  v_mov_b32 v139, v138
  s_nop 1
  v_permlane16_swap_b32 v138, v139
  s_nop 0
  v_add_f32 v138, v138, v139
  v_rcp_f32 v138, v138
  s_nop 0
  v_mul_f32 v128, v128, v138
  v_mul_f32 v129, v129, v138
  v_mul_f32 v130, v130, v138
  v_mul_f32 v131, v131, v138
  v_cvt_pk_bf16_f32 v136, v128, v129
  v_cvt_pk_bf16_f32 v137, v130, v131
  v_lshlrev_b32 v128, 16, v136
  v_and_b32 v129, 0xffff0000, v136
  v_lshlrev_b32 v130, 16, v137
  v_and_b32 v131, 0xffff0000, v137
L_loop2:
  s_waitcnt vmcnt(9)
  v_perm_b32 v12, v60, v56, s45
  v_perm_b32 v13, v68, v64, s45
  v_perm_b32 v14, v76, v72, s45
  v_perm_b32 v15, v84, v80, s45
  v_perm_b32 v16, v60, v56, s46
  v_perm_b32 v17, v68, v64, s46
  v_perm_b32 v18, v76, v72, s46
  v_perm_b32 v19, v84, v80, s46
  v_mfma_f32_16x16x32_bf16 v[24:27], v[88:91], v[12:15], v[24:27]
  v_perm_b32 v12, v61, v57, s45
  v_perm_b32 v13, v69, v65, s45
  v_perm_b32 v14, v77, v73, s45
  v_perm_b32 v15, v85, v81, s45
  v_mfma_f32_16x16x32_bf16 v[28:31], v[88:91], v[16:19], v[28:31]
  v_perm_b32 v16, v61, v57, s46
  v_perm_b32 v17, v69, v65, s46
  v_perm_b32 v18, v77, v73, s46
  v_perm_b32 v19, v85, v81, s46
  v_mfma_f32_16x16x32_bf16 v[32:35], v[88:91], v[12:15], v[32:35]
  v_perm_b32 v12, v62, v58, s45
  v_perm_b32 v13, v70, v66, s45
  v_perm_b32 v14, v78, v74, s45
  v_perm_b32 v15, v86, v82, s45
  v_mfma_f32_16x16x32_bf16 v[36:39], v[88:91], v[16:19], v[36:39]
  v_perm_b32 v16, v62, v58, s46
  v_perm_b32 v17, v70, v66, s46
  v_perm_b32 v18, v78, v74, s46
  v_perm_b32 v19, v86, v82, s46
  v_mfma_f32_16x16x32_bf16 v[40:43], v[88:91], v[12:15], v[40:43]
  v_perm_b32 v12, v63, v59, s45
  v_perm_b32 v13, v71, v67, s45
  v_perm_b32 v14, v79, v75, s45
  v_perm_b32 v15, v87, v83, s45
  v_mfma_f32_16x16x32_bf16 v[44:47], v[88:91], v[16:19], v[44:47]
  v_perm_b32 v16, v63, v59, s46
  v_perm_b32 v17, v71, v67, s46
  v_perm_b32 v18, v79, v75, s46
  v_perm_b32 v19, v87, v83, s46
  v_mfma_f32_16x16x32_bf16 v[48:51], v[88:91], v[12:15], v[48:51]
  s_nop 1
  v_mfma_f32_16x16x32_bf16 v[52:55], v[88:91], v[16:19], v[52:55]
  s_lshr_b32 s43, s42, 7
  buffer_load_dwordx4 v[88:91], v2, s[24:27], s43 offen
  s_waitcnt vmcnt(9)
  buffer_load_dwordx4 v[56:59], v1, s[20:23], s42 offen offset:0 nt
  s_waitcnt vmcnt(9)
  buffer_load_dwordx4 v[60:63], v1, s[20:23], s42 offen offset:256 nt
  s_waitcnt vmcnt(9)
  buffer_load_dwordx4 v[64:67], v1, s[20:23], s42 offen offset:512 nt
  s_waitcnt vmcnt(9)
  buffer_load_dwordx4 v[68:71], v1, s[20:23], s42 offen offset:768 nt
  s_waitcnt vmcnt(9)
  buffer_load_dwordx4 v[72:75], v1, s[20:23], s42 offen offset:1024 nt
  s_waitcnt vmcnt(9)
  buffer_load_dwordx4 v[76:79], v1, s[20:23], s42 offen offset:1280 nt
  s_waitcnt vmcnt(9)
  buffer_load_dwordx4 v[80:83], v1, s[20:23], s42 offen offset:1536 nt
  s_waitcnt vmcnt(9)
  buffer_load_dwordx4 v[84:87], v1, s[20:23], s42 offen offset:1792 nt
  s_add_u32 s42, s42, 32768
  s_waitcnt vmcnt(9)
  v_perm_b32 v12, v96, v92, s45
  v_perm_b32 v13, v104, v100, s45
  v_perm_b32 v14, v112, v108, s45
  v_perm_b32 v15, v120, v116, s45
  v_perm_b32 v16, v96, v92, s46
  v_perm_b32 v17, v104, v100, s46
  v_perm_b32 v18, v112, v108, s46
  v_perm_b32 v19, v120, v116, s46
  v_mfma_f32_16x16x32_bf16 v[24:27], v[124:127], v[12:15], v[24:27]
  v_perm_b32 v12, v97, v93, s45
  v_perm_b32 v13, v105, v101, s45
  v_perm_b32 v14, v113, v109, s45
  v_perm_b32 v15, v121, v117, s45
  v_mfma_f32_16x16x32_bf16 v[28:31], v[124:127], v[16:19], v[28:31]
  v_perm_b32 v16, v97, v93, s46
  v_perm_b32 v17, v105, v101, s46
  v_perm_b32 v18, v113, v109, s46
  v_perm_b32 v19, v121, v117, s46
  v_mfma_f32_16x16x32_bf16 v[32:35], v[124:127], v[12:15], v[32:35]
  v_perm_b32 v12, v98, v94, s45
  v_perm_b32 v13, v106, v102, s45
  v_perm_b32 v14, v114, v110, s45
  v_perm_b32 v15, v122, v118, s45
  v_mfma_f32_16x16x32_bf16 v[36:39], v[124:127], v[16:19], v[36:39]
  v_perm_b32 v16, v98, v94, s46
  v_perm_b32 v17, v106, v102, s46
  v_perm_b32 v18, v114, v110, s46
  v_perm_b32 v19, v122, v118, s46
  v_mfma_f32_16x16x32_bf16 v[40:43], v[124:127], v[12:15], v[40:43]
  v_perm_b32 v12, v99, v95, s45
  v_perm_b32 v13, v107, v103, s45
  v_perm_b32 v14, v115, v111, s45
  v_perm_b32 v15, v123, v119, s45
  v_mfma_f32_16x16x32_bf16 v[44:47], v[124:127], v[16:19], v[44:47]
  v_perm_b32 v16, v99, v95, s46
  v_perm_b32 v17, v107, v103, s46
  v_perm_b32 v18, v115, v111, s46
  v_perm_b32 v19, v123, v119, s46
  v_mfma_f32_16x16x32_bf16 v[48:51], v[124:127], v[12:15], v[48:51]
  s_nop 1
  v_mfma_f32_16x16x32_bf16 v[52:55], v[124:127], v[16:19], v[52:55]
  s_lshr_b32 s43, s42, 7
  buffer_load_dwordx4 v[124:127], v2, s[24:27], s43 offen
  s_waitcnt vmcnt(9)
  buffer_load_dwordx4 v[92:95], v1, s[20:23], s42 offen offset:0 nt
  s_waitcnt vmcnt(9)
  buffer_load_dwordx4 v[96:99], v1, s[20:23], s42 offen offset:256 nt
  s_waitcnt vmcnt(9)
  buffer_load_dwordx4 v[100:103], v1, s[20:23], s42 offen offset:512 nt
  s_waitcnt vmcnt(9)
  buffer_load_dwordx4 v[104:107], v1, s[20:23], s42 offen offset:768 nt
  s_waitcnt vmcnt(9)
  buffer_load_dwordx4 v[108:111], v1, s[20:23], s42 offen offset:1024 nt
  s_waitcnt vmcnt(9)
  buffer_load_dwordx4 v[112:115], v1, s[20:23], s42 offen offset:1280 nt
  s_waitcnt vmcnt(9)
  buffer_load_dwordx4 v[116:119], v1, s[20:23], s42 offen offset:1536 nt
  s_waitcnt vmcnt(9)
  buffer_load_dwordx4 v[120:123], v1, s[20:23], s42 offen offset:1792 nt
  s_add_u32 s42, s42, 32768
  s_add_u32 s41, s41, 1
  s_cmp_lt_u32 s41, 31
  s_cbranch_scc1 L_loop2
  s_waitcnt vmcnt(9)
  v_perm_b32 v12, v60, v56, s45
  v_perm_b32 v13, v68, v64, s45
  v_perm_b32 v14, v76, v72, s45
  v_perm_b32 v15, v84, v80, s45
  v_perm_b32 v16, v60, v56, s46
  v_perm_b32 v17, v68, v64, s46
  v_perm_b32 v18, v76, v72, s46
  v_perm_b32 v19, v84, v80, s46
  v_mfma_f32_16x16x32_bf16 v[24:27], v[88:91], v[12:15], v[24:27]
  v_perm_b32 v12, v61, v57, s45
  v_perm_b32 v13, v69, v65, s45
  v_perm_b32 v14, v77, v73, s45
  v_perm_b32 v15, v85, v81, s45
  v_mfma_f32_16x16x32_bf16 v[28:31], v[88:91], v[16:19], v[28:31]
  v_perm_b32 v16, v61, v57, s46
  v_perm_b32 v17, v69, v65, s46
  v_perm_b32 v18, v77, v73, s46
  v_perm_b32 v19, v85, v81, s46
  v_mfma_f32_16x16x32_bf16 v[32:35], v[88:91], v[12:15], v[32:35]
  v_perm_b32 v12, v62, v58, s45
  v_perm_b32 v13, v70, v66, s45
  v_perm_b32 v14, v78, v74, s45
  v_perm_b32 v15, v86, v82, s45
  v_mfma_f32_16x16x32_bf16 v[36:39], v[88:91], v[16:19], v[36:39]
  v_perm_b32 v16, v62, v58, s46
  v_perm_b32 v17, v70, v66, s46
  v_perm_b32 v18, v78, v74, s46
  v_perm_b32 v19, v86, v82, s46
  v_mfma_f32_16x16x32_bf16 v[40:43], v[88:91], v[12:15], v[40:43]
  v_perm_b32 v12, v63, v59, s45
  v_perm_b32 v13, v71, v67, s45
  v_perm_b32 v14, v79, v75, s45
  v_perm_b32 v15, v87, v83, s45
  v_mfma_f32_16x16x32_bf16 v[44:47], v[88:91], v[16:19], v[44:47]
  v_perm_b32 v16, v63, v59, s46
  v_perm_b32 v17, v71, v67, s46
  v_perm_b32 v18, v79, v75, s46
  v_perm_b32 v19, v87, v83, s46
  v_mfma_f32_16x16x32_bf16 v[48:51], v[88:91], v[12:15], v[48:51]
  s_nop 1
  v_mfma_f32_16x16x32_bf16 v[52:55], v[88:91], v[16:19], v[52:55]
  s_waitcnt vmcnt(0)
  v_perm_b32 v12, v96, v92, s45
  v_perm_b32 v13, v104, v100, s45
  v_perm_b32 v14, v112, v108, s45
  v_perm_b32 v15, v120, v116, s45
  v_perm_b32 v16, v96, v92, s46
  v_perm_b32 v17, v104, v100, s46
  v_perm_b32 v18, v112, v108, s46
  v_perm_b32 v19, v120, v116, s46
  v_mfma_f32_16x16x32_bf16 v[24:27], v[124:127], v[12:15], v[24:27]
  v_perm_b32 v12, v97, v93, s45
  v_perm_b32 v13, v105, v101, s45
  v_perm_b32 v14, v113, v109, s45
  v_perm_b32 v15, v121, v117, s45
  v_mfma_f32_16x16x32_bf16 v[28:31], v[124:127], v[16:19], v[28:31]
  v_perm_b32 v16, v97, v93, s46
  v_perm_b32 v17, v105, v101, s46
  v_perm_b32 v18, v113, v109, s46
  v_perm_b32 v19, v121, v117, s46
  v_mfma_f32_16x16x32_bf16 v[32:35], v[124:127], v[12:15], v[32:35]
  v_perm_b32 v12, v98, v94, s45
  v_perm_b32 v13, v106, v102, s45
  v_perm_b32 v14, v114, v110, s45
  v_perm_b32 v15, v122, v118, s45
  v_mfma_f32_16x16x32_bf16 v[36:39], v[124:127], v[16:19], v[36:39]
  v_perm_b32 v16, v98, v94, s46
  v_perm_b32 v17, v106, v102, s46
  v_perm_b32 v18, v114, v110, s46
  v_perm_b32 v19, v122, v118, s46
  v_mfma_f32_16x16x32_bf16 v[40:43], v[124:127], v[12:15], v[40:43]
  v_perm_b32 v12, v99, v95, s45
  v_perm_b32 v13, v107, v103, s45
  v_perm_b32 v14, v115, v111, s45
  v_perm_b32 v15, v123, v119, s45
  v_mfma_f32_16x16x32_bf16 v[44:47], v[124:127], v[16:19], v[44:47]
  v_perm_b32 v16, v99, v95, s46
  v_perm_b32 v17, v107, v103, s46
  v_perm_b32 v18, v115, v111, s46
  v_perm_b32 v19, v123, v119, s46
  v_mfma_f32_16x16x32_bf16 v[48:51], v[124:127], v[12:15], v[48:51]
  s_nop 1
  v_mfma_f32_16x16x32_bf16 v[52:55], v[124:127], v[16:19], v[52:55]
  s_nop 7
  s_mov_b32 exec_hi, 0
  ds_write_b128 v4, v[24:27] offset:0
  ds_write_b128 v4, v[28:31] offset:512
  ds_write_b128 v4, v[32:35] offset:1024
  ds_write_b128 v4, v[36:39] offset:1536
  ds_write_b128 v4, v[40:43] offset:2048
  ds_write_b128 v4, v[44:47] offset:2560
  ds_write_b128 v4, v[48:51] offset:3072
  ds_write_b128 v4, v[52:55] offset:3584
  s_mov_b32 exec_hi, -1
  s_waitcnt lgkmcnt(0)
  s_barrier
  ds_read_b128 v[140:143], v132 offset:0
  ds_read_b128 v[144:147], v132 offset:4096
  ds_read_b128 v[148:151], v132 offset:8192
  ds_read_b128 v[152:155], v132 offset:12288
  s_waitcnt lgkmcnt(2)
  v_add_f32 v140, v140, v144
  v_add_f32 v141, v141, v145
  v_add_f32 v142, v142, v146
  v_add_f32 v143, v143, v147
  s_waitcnt lgkmcnt(0)
  v_add_f32 v148, v148, v152
  v_add_f32 v149, v149, v153
  v_add_f32 v150, v150, v154
  v_add_f32 v151, v151, v155
  v_add_f32 v140, v140, v148
  v_add_f32 v141, v141, v149
  v_add_f32 v142, v142, v150
  v_add_f32 v143, v143, v151
  v_cvt_pk_bf16_f32 v136, v140, v141
  v_cvt_pk_bf16_f32 v137, v142, v143
  v_lshlrev_b32 v140, 16, v136
  v_and_b32 v141, 0xffff0000, v136
  v_lshlrev_b32 v142, 16, v137
  v_and_b32 v143, 0xffff0000, v137
  v_mul_f32 v138, v140, v128
  v_fmac_f32 v138, v141, v129
  v_fmac_f32 v138, v142, v130
  v_fmac_f32 v138, v143, v131
  v_mov_b32 v139, v138
  s_nop 1
  v_permlane16_swap_b32 v138, v139
  s_nop 0
  v_add_f32 v138, v138, v139
  v_mov_b32 v139, v138
  s_nop 1
  v_permlane32_swap_b32 v138, v139
  s_nop 0
  v_cvt_pk_bf16_f32 v138, v138, v139
  s_mov_b32 exec_hi, 0
  s_mov_b32 exec_lo, 0xffff
  buffer_store_dword v138, v156, s[28:31], s49 offen
  s_endpgm
L_trans:
  v_lshlrev_b32 v12, 16, v20
  v_and_b32 v13, 0xffff0000, v20
  v_lshlrev_b32 v14, 16, v21
  v_and_b32 v15, 0xffff0000, v21
  v_lshlrev_b32 v16, 16, v22
  v_and_b32 v17, 0xffff0000, v22
  v_lshlrev_b32 v18, 16, v23
  v_and_b32 v19, 0xffff0000, v23
  s_nop 3
  v_mul_f32 v8, v24, v12
  v_mul_f32 v9, v25, v12
  v_mul_f32 v10, v26, v12
  v_mul_f32 v11, v27, v12
  v_fmac_f32 v8, v28, v13
  v_fmac_f32 v9, v29, v13
  v_fmac_f32 v10, v30, v13
  v_fmac_f32 v11, v31, v13
  v_fmac_f32 v8, v32, v14
  v_fmac_f32 v9, v33, v14
  v_fmac_f32 v10, v34, v14
  v_fmac_f32 v11, v35, v14
  v_fmac_f32 v8, v36, v15
  v_fmac_f32 v9, v37, v15
  v_fmac_f32 v10, v38, v15
  v_fmac_f32 v11, v39, v15
  v_fmac_f32 v8, v40, v16
  v_fmac_f32 v9, v41, v16
  v_fmac_f32 v10, v42, v16
  v_fmac_f32 v11, v43, v16
  v_fmac_f32 v8, v44, v17
  v_fmac_f32 v9, v45, v17
  v_fmac_f32 v10, v46, v17
  v_fmac_f32 v11, v47, v17
  v_fmac_f32 v8, v48, v18
  v_fmac_f32 v9, v49, v18
  v_fmac_f32 v10, v50, v18
  v_fmac_f32 v11, v51, v18
  v_fmac_f32 v8, v52, v19
  v_fmac_f32 v9, v53, v19
  v_fmac_f32 v10, v54, v19
  v_fmac_f32 v11, v55, v19
  v_add_f32_dpp v8, v8, v8 row_ror:8 row_mask:0xf bank_mask:0xf
  v_add_f32_dpp v9, v9, v9 row_ror:8 row_mask:0xf bank_mask:0xf
  v_add_f32_dpp v10, v10, v10 row_ror:8 row_mask:0xf bank_mask:0xf
  v_add_f32_dpp v11, v11, v11 row_ror:8 row_mask:0xf bank_mask:0xf
  v_add_f32_dpp v8, v8, v8 row_ror:4 row_mask:0xf bank_mask:0xf
  v_add_f32_dpp v9, v9, v9 row_ror:4 row_mask:0xf bank_mask:0xf
  v_add_f32_dpp v10, v10, v10 row_ror:4 row_mask:0xf bank_mask:0xf
  v_add_f32_dpp v11, v11, v11 row_ror:4 row_mask:0xf bank_mask:0xf
  v_add_f32_dpp v8, v8, v8 row_ror:2 row_mask:0xf bank_mask:0xf
  v_add_f32_dpp v9, v9, v9 row_ror:2 row_mask:0xf bank_mask:0xf
  v_add_f32_dpp v10, v10, v10 row_ror:2 row_mask:0xf bank_mask:0xf
  v_add_f32_dpp v11, v11, v11 row_ror:2 row_mask:0xf bank_mask:0xf
  v_add_f32_dpp v8, v8, v8 row_ror:1 row_mask:0xf bank_mask:0xf
  v_add_f32_dpp v9, v9, v9 row_ror:1 row_mask:0xf bank_mask:0xf
  v_add_f32_dpp v10, v10, v10 row_ror:1 row_mask:0xf bank_mask:0xf
  v_add_f32_dpp v11, v11, v11 row_ror:1 row_mask:0xf bank_mask:0xf
  s_lshl_b32 s47, s40, 5
  s_add_u32 s47, s47, 0
  v_add_u32 v136, s47, v0
  s_mov_b32 exec_lo, 0x10001
  s_mov_b32 exec_hi, 0
  ds_write_b128 v136, v[8:11]
  s_mov_b64 exec, -1
  v_mov_b32 v24, 0
  v_mov_b32 v25, 0
  v_mov_b32 v26, 0
  v_mov_b32 v27, 0
  v_mov_b32 v28, 0
  v_mov_b32 v29, 0
  v_mov_b32 v30, 0
  v_mov_b32 v31, 0
  v_mov_b32 v32, 0
  v_mov_b32 v33, 0
  v_mov_b32 v34, 0
  v_mov_b32 v35, 0
  v_mov_b32 v36, 0
  v_mov_b32 v37, 0
  v_mov_b32 v38, 0
  v_mov_b32 v39, 0
  v_mov_b32 v40, 0
  v_mov_b32 v41, 0
  v_mov_b32 v42, 0
  v_mov_b32 v43, 0
  v_mov_b32 v44, 0
  v_mov_b32 v45, 0
  v_mov_b32 v46, 0
  v_mov_b32 v47, 0
  v_mov_b32 v48, 0
  v_mov_b32 v49, 0
  v_mov_b32 v50, 0
  v_mov_b32 v51, 0
  v_mov_b32 v52, 0
  v_mov_b32 v53, 0
  v_mov_b32 v54, 0
  v_mov_b32 v55, 0
  s_branch L_body
L_end:
  s_endpgm
L_codeend:
.section .rodata,"a"
.p2align 6
.amdhsa_kernel standalone__low_rank_proj_linformer__decode_kernel
  .amdhsa_next_free_vgpr 160
  .amdhsa_next_free_sgpr 96
  .amdhsa_accum_offset 160
  .amdhsa_group_segment_fixed_size 0
  .amdhsa_kernarg_size 64
  .amdhsa_user_sgpr_count 2
  .amdhsa_user_sgpr_kernarg_segment_ptr 1
  .amdhsa_system_sgpr_workgroup_id_x 1
.end_amdhsa_kernel
```
